```python
import torch

def _softmax(x, axis=-1):
    return torch.softmax(x, dim=axis)
def _gelu(x):
    return torch.nn.functional.gelu(x, approximate="tanh")
def _silu(x):
    return torch.nn.functional.silu(x)
def _sigmoid(x):
    return torch.sigmoid(x)
def _layernorm(x, axis=-1, eps=1e-5):
    m = x.mean(dim=axis, keepdim=True)
    v = x.var(dim=axis, keepdim=True, unbiased=False)
    return (x - m) / torch.sqrt(v + eps)
def _scatter_add(tgt, idx, src, axis=0):
    return tgt.clone().index_add_(axis, idx, src)
def _segment_sum(src, seg, n):
    out = torch.zeros((n,) + src.shape[1:], dtype=src.dtype)
    return out.index_add_(0, seg, src)
def _pad(x, pw):
    flat = tuple(v for pair in reversed(pw) for v in pair)
    return torch.nn.functional.pad(x, flat)

kernel_name = 'interleave_layers__sliding_block_cached__glu_gated_swiglu__decode'

def setup_inputs():

    _w = (lambda a: (lambda t: t.to(torch.bfloat16) if t.is_floating_point() else t)(torch.as_tensor(a)))
    def _A_setup():
        B, Sq, D = 1, 1, 448
        Hq, Hkv, Sk, Dh = 16, 8, 8192, 256
        assert Hq % Hkv == 0, (Hq, Hkv)
        return {
            "x": _w((lambda *s: torch.randn(*s, dtype=torch.bfloat16) * 0.05)(B, Sq, D)),
            "k_cache": _w((lambda *s: torch.randn(*s, dtype=torch.bfloat16) * 1.6)(B, Hkv, Sk, Dh)),
            "v_cache": _w((lambda *s: torch.randn(*s, dtype=torch.bfloat16) * 0.8)(B, Hkv, Sk, Dh)),
            "wq": _w((lambda *s: torch.randn(*s, dtype=torch.bfloat16) * 1.6)(D, Hq * Dh) * (D ** -0.5)),
            "wo": _w((lambda *s: torch.randn(*s, dtype=torch.bfloat16) * 0.8)(Hq * Dh, D) * ((Hq * Dh) ** -0.5)),
        }
    _A_in = _A_setup()

    def _B_setup():
        B, S, D, F = 1, 1, 448, 1792
        return {
            "x": _w((lambda *s: torch.randn(*s, dtype=torch.bfloat16) * 0.05)(B, S, D)),
            "w1": _w((lambda *s: torch.randn(*s, dtype=torch.bfloat16) * 0.4)(D, F) * (2.0 / D) ** 0.5),
            "w3": _w((lambda *s: torch.randn(*s, dtype=torch.bfloat16) * 0.4)(D, F) * (2.0 / D) ** 0.5),
            "w2": _w((lambda *s: torch.randn(*s, dtype=torch.bfloat16) * 0.4)(F, D) * (2.0 / F) ** 0.5),
        }
    _B_in = _B_setup()

    return {
        "A_x": _A_in["x"],
        "A_k_cache": _A_in["k_cache"],
        "A_v_cache": _A_in["v_cache"],
        "A_wq": _A_in["wq"],
        "A_wo": _A_in["wo"],
        "B_x": _B_in["x"],
        "B_w1": _B_in["w1"],
        "B_w3": _B_in["w3"],
        "B_w2": _B_in["w2"],
    }

def reference(A_x, A_k_cache, A_v_cache, A_wq, A_wo, B_x, B_w1, B_w3, B_w2):
    def _A_ref(x, k_cache, v_cache, wq, wo):
        B, Sq, D = x.shape
        Hq, Dh = 16, 256
        Hkv, Sk = k_cache.shape[1], k_cache.shape[2]
        W = min(4096, max(256, Sk // 4))
        rep = Hq // Hkv
        q = (lambda x, *d: x.permute(*d))((x @ wq).reshape(B, Sq, Hq, Dh), 0, 2, 1, 3)
        k = (lambda x, n, axis: torch.repeat_interleave(x, n, dim=axis))(k_cache[:, :, Sk - W:, :], rep, axis=1)
        v = (lambda x, n, axis: torch.repeat_interleave(x, n, dim=axis))(v_cache[:, :, Sk - W:, :], rep, axis=1)
        scores = torch.einsum("bhqd,bhkd->bhqk", q, k) * (Dh ** -0.5)
        p = _softmax(scores, axis=-1)
        o = torch.einsum("bhqk,bhkd->bhqd", p, v)
        return (lambda x, *d: x.permute(*d))(o, 0, 2, 1, 3).reshape(B, Sq, Hq * Dh) @ wo

    def _B_ref(x, w1, w3, w2):
        gate = torch.einsum("bsd,df->bsf", x, w1)
        up = torch.einsum("bsd,df->bsf", x, w3)
        h = _silu(gate) * up
        out = torch.einsum("bsf,fd->bsd", h, w2)
        return out

    x = A_x
    x = x + _A_ref(_layernorm(x, axis=-1), A_k_cache, A_v_cache, A_wq, A_wo)
    x = x + _B_ref(_layernorm(x, axis=-1), B_w1, B_w3, B_w2)
    x = x + _A_ref(_layernorm(x, axis=-1), A_k_cache, A_v_cache, A_wq, A_wo)
    x = x + _B_ref(_layernorm(x, axis=-1), B_w1, B_w3, B_w2)
    return x
```

```asm
; @launch grid=(256,1,1) block=(256,1,1) lds=86016
.amdgcn_target "amdgcn-amd-amdhsa--gfx950"
.text
.globl interleave_layers__sliding_block_cached__glu_gated_swiglu__decode_kernel
.p2align 8
.type interleave_layers__sliding_block_cached__glu_gated_swiglu__decode_kernel,@function
interleave_layers__sliding_block_cached__glu_gated_swiglu__decode_kernel:
    s_cmp_ge_u32 s2, 256
    s_cbranch_scc1 L_end
    s_mov_b32 s73, 0
    s_load_dwordx16 s[4:19], s[0:1], 0
    s_load_dwordx8 s[20:27], s[0:1], 64
    v_lshrrev_b32 v40, 6, v0
    v_and_b32 v0, 63, v0
    v_readfirstlane_b32 s70, v40
    s_and_b32 s68, s2, 7
    s_lshr_b32 s69, s2, 3
    s_getreg_b32 s74, hwreg(HW_REG_XCC_ID, 0, 4)
    v_and_b32 v41, 15, v0
    v_lshrrev_b32 v42, 4, v0
    v_lshrrev_b32 v43, 5, v0
    v_and_b32 v44, 31, v0
    v_min_u32 v44, 27, v44
    s_mul_i32 s75, s70, 28
    v_add_u32 v44, s75, v44
    v_lshlrev_b32 v45, 3, v44
    v_lshl_add_u32 v45, v43, 2, v45
    v_lshrrev_b32 v46, 1, v0
    v_lshlrev_b32 v46, 13, v46
    v_and_b32 v49, 1, v0
    v_lshl_add_u32 v46, v49, 4, v46
    s_lshl_b32 s75, s70, 13
    v_lshlrev_b32 v47, 9, v41
    v_lshl_add_u32 v47, v42, 4, v47
    v_add_u32 v47, s75, v47
    v_lshlrev_b32 v49, 1, v43
    v_and_b32 v48, 31, v0
    v_xor_b32 v48, v48, v49
    v_lshlrev_b32 v48, 4, v48
    v_lshl_add_u32 v48, v43, 9, v48
    s_lshl_b32 s98, s68, 22
    s_lshl_b32 s75, s69, 15
    s_add_u32 s98, s98, s75
    s_add_u32 s98, s98, 3145728
    s_lshl_b32 s78, s68, 10
    s_lshl_b32 s75, s69, 5
    s_add_u32 s78, s78, s75
    s_lshl_b32 s75, s70, 18
    s_add_u32 s78, s78, s75
    s_lshl_b32 s79, s70, 10
    s_add_u32 s79, s79, 32768
    s_and_b32 s80, s69, 3
    s_waitcnt lgkmcnt(0)
    s_load_dword s71, s[26:27], 0
    s_mov_b32 s28, s4
    s_and_b32 s29, s5, 0xffff
    s_mov_b32 s30, 896
    s_mov_b32 s31, 0x20000
    s_mov_b32 s40, s10
    s_and_b32 s41, s11, 0xffff
    s_mov_b32 s42, 3670016
    s_mov_b32 s43, 0x20000
    buffer_load_dword v19, v45, s[28:31], 0 offen
    s_mov_b32 s32, s6
    s_and_b32 s33, s7, 0xffff
    s_mov_b32 s34, 33554432
    s_mov_b32 s35, 0x20000
    v_mov_b32 v18, v47
    s_lshl_b32 s75, s80, 12
    s_add_u32 m0, s79, s75
    s_lshl_b32 s75, s80, 20
    s_add_u32 s75, s75, s78
    buffer_load_dwordx4 v46, s[40:43], s75 offen nt lds
    s_add_u32 s80, s80, 1
    s_and_b32 s80, s80, 3
    s_lshl_b32 s75, s80, 12
    s_add_u32 m0, s79, s75
    s_lshl_b32 s75, s80, 20
    s_add_u32 s75, s75, s78
    buffer_load_dwordx4 v46, s[40:43], s75 offen nt lds
    s_add_u32 s80, s80, 1
    s_and_b32 s80, s80, 3
    s_lshl_b32 s75, s80, 12
    s_add_u32 m0, s79, s75
    s_lshl_b32 s75, s80, 20
    s_add_u32 s75, s75, s78
    buffer_load_dwordx4 v46, s[40:43], s75 offen nt lds
    s_add_u32 s80, s80, 1
    s_and_b32 s80, s80, 3
    s_lshl_b32 s75, s80, 12
    s_add_u32 m0, s79, s75
    s_lshl_b32 s75, s80, 20
    s_add_u32 s75, s75, s78
    buffer_load_dwordx4 v46, s[40:43], s75 offen nt lds
    v_mov_b32 v23, v48
    s_mov_b32 s36, s8
    s_and_b32 s37, s9, 0xffff
    s_mov_b32 s38, 33554432
    s_mov_b32 s39, 0x20000
    s_mov_b32 s64, s26
    s_and_b32 s65, s27, 0xffff
    s_mov_b32 s66, 8388608
    s_mov_b32 s67, 0x20000
    s_mov_b32 s44, s12
    s_and_b32 s45, s13, 0xffff
    s_mov_b32 s46, 3670016
    s_mov_b32 s47, 0x20000
    s_mov_b32 s48, s16
    s_and_b32 s49, s17, 0xffff
    s_mov_b32 s50, 1605632
    s_mov_b32 s51, 0x20000
    s_mov_b32 s52, s18
    s_and_b32 s53, s19, 0xffff
    s_mov_b32 s54, 1605632
    s_mov_b32 s55, 0x20000
    s_mov_b32 s56, s20
    s_and_b32 s57, s21, 0xffff
    s_mov_b32 s58, 1605632
    s_mov_b32 s59, 0x20000
    s_mov_b32 s60, s22
    s_and_b32 s61, s23, 0xffff
    s_mov_b32 s62, 896
    s_mov_b32 s63, 0x20000
    s_mov_b64 exec, 1
    v_mov_b32 v51, 0
    buffer_load_dword v248, v51, s[36:39], s98 offen nt
    s_mul_i32 s75, s68, 458752
    buffer_load_dword v248, v51, s[44:47], s75 offen nt
    buffer_load_dword v248, v51, s[48:51], 0 offen
    buffer_load_dword v248, v51, s[52:55], 0 offen
    buffer_load_dword v248, v51, s[56:59], 0 offen
    s_mov_b32 s75, 4259840
    buffer_load_dword v248, v51, s[64:67], s75 offen
    buffer_load_dword v248, v51, s[64:67], 0 offen offset:256
    s_mov_b64 exec, -1
    v_lshrrev_b32 v51, 3, v44
    v_lshlrev_b32 v2, 6, v51
    v_and_b32 v51, 3, v44
    v_lshl_add_u32 v2, v51, 4, v2
    v_bfe_u32 v51, v44, 2, 1
    v_lshl_add_u32 v2, v51, 3, v2
    v_lshl_add_u32 v2, v43, 2, v2
    v_add_u32 v2, 65664, v2
    v_mul_u32_u24 v1, 7168, v43
    v_lshl_add_u32 v1, v44, 4, v1
    v_lshlrev_b32 v3, 4, v42
    s_lshl_b32 s75, s68, 11
    s_lshl_b32 s78, s69, 6
    s_add_u32 s78, s78, s75
    v_add_u32 v15, s78, v3
    v_add_u32 v3, 65664, v3
    v_lshlrev_b32 v4, 4, v0
    v_add_u32 v4, 65664, v4
    v_mov_b32 v51, 66656
    v_cmp_gt_u32 vcc, 56, v0
    v_cndmask_b32 v4, v51, v4, vcc
    v_mov_b32 v32, 0
    v_mov_b32 v33, 0
    v_mov_b32 v34, 0
    v_mov_b32 v35, 0
    ds_write_b128 v51, v[32:35]
    s_mov_b32 s20, 0xfffffff
    s_mov_b32 s21, 0xfffffff
    s_mov_b32 s4, 0x10001
    s_mov_b32 s5, 0x10001
    s_mov_b32 s93, 0xffff0000
    s_mov_b32 s72, 1
    s_mov_b32 s77, 0
    s_mov_b32 s99, 57472
    s_mov_b32 s84, 4096
    v_mov_b32 v24, 0x3f803f80
    v_mov_b32 v25, 0x3f803f80
    v_mov_b32 v26, 0x3f803f80
    v_mov_b32 v27, 0x3f803f80
    s_branch L_kiss
L_layer:
L_kiss_back:
    s_waitcnt lgkmcnt(0)
    s_barrier
    s_mov_b32 s76, s71
    s_cmp_lg_u32 s70, 3
    s_cbranch_scc1 L_not_q
    s_cmp_eq_u32 s73, 0
    s_cbranch_scc1 L_prep_wq
L_prep_wq_back:
    ds_read_b128 v[48:51], v4
    v_mov_b32 v36, 0
    v_mov_b32 v37, 0
    s_waitcnt lgkmcnt(0)
    v_dot2c_f32_bf16 v36, v48, v24
    v_dot2c_f32_bf16 v37, v48, v48
    v_dot2c_f32_bf16 v36, v49, v24
    v_dot2c_f32_bf16 v37, v49, v49
    v_dot2c_f32_bf16 v36, v50, v24
    v_dot2c_f32_bf16 v37, v50, v50
    v_dot2c_f32_bf16 v36, v51, v24
    v_dot2c_f32_bf16 v37, v51, v51
    v_lshlrev_b32 v52, 16, v48
    v_and_b32 v53, s93, v48
    v_lshlrev_b32 v54, 16, v49
    v_and_b32 v55, s93, v49
    v_permlane32_swap_b32 v36, v37
    v_add_f32 v36, v36, v37
    v_mov_b32 v37, v36
    v_lshlrev_b32 v56, 16, v50
    v_and_b32 v57, s93, v50
    v_permlane16_swap_b32 v36, v37
    v_add_f32 v36, v36, v37
    v_lshlrev_b32 v58, 16, v51
    v_and_b32 v59, s93, v51
    v_add_f32_dpp v36, v36, v36 row_ror:8 row_mask:0xf bank_mask:0xf
    s_nop 1
    v_add_f32_dpp v36, v36, v36 row_ror:4 row_mask:0xf bank_mask:0xf
    s_nop 1
    v_add_f32_dpp v36, v36, v36 row_ror:2 row_mask:0xf bank_mask:0xf
    s_nop 1
    v_add_f32_dpp v36, v36, v36 row_ror:1 row_mask:0xf bank_mask:0xf
    v_mul_f32 v36, 0x3b124925, v36
    v_mov_b32 v37, v36
    s_nop 1
    v_permlane32_swap_b32 v36, v37
    v_fma_f32 v37, -v36, v36, v37
    v_max_f32 v37, 0, v37
    v_cvt_pk_bf16_f32 v44, v36, v37
    v_lshlrev_b32 v22, 16, v44
    v_and_b32 v44, s93, v44
    v_add_f32 v44, 0x3727c5ac, v44
    v_cvt_pk_bf16_f32 v44, v44, v44
    v_and_b32 v44, s93, v44
    v_sqrt_f32 v44, v44
    v_pk_add_f32 v[52:53], v[52:53], v[22:23] op_sel_hi:[1,0] neg_lo:[0,1] neg_hi:[0,1]
    v_pk_add_f32 v[54:55], v[54:55], v[22:23] op_sel_hi:[1,0] neg_lo:[0,1] neg_hi:[0,1]
    v_pk_add_f32 v[56:57], v[56:57], v[22:23] op_sel_hi:[1,0] neg_lo:[0,1] neg_hi:[0,1]
    v_pk_add_f32 v[58:59], v[58:59], v[22:23] op_sel_hi:[1,0] neg_lo:[0,1] neg_hi:[0,1]
    v_cvt_pk_bf16_f32 v48, v52, v53
    v_cvt_pk_bf16_f32 v49, v54, v55
    v_cvt_pk_bf16_f32 v50, v56, v57
    v_cvt_pk_bf16_f32 v51, v58, v59
    s_nop 0
    v_cvt_pk_bf16_f32 v44, v44, v44
    v_and_b32 v44, s93, v44
    v_rcp_f32 v23, v44
    v_lshlrev_b32 v52, 16, v48
    v_and_b32 v53, s93, v48
    v_lshlrev_b32 v54, 16, v49
    v_and_b32 v55, s93, v49
    v_lshlrev_b32 v56, 16, v50
    v_and_b32 v57, s93, v50
    v_lshlrev_b32 v58, 16, v51
    v_and_b32 v59, s93, v51
    v_pk_mul_f32 v[52:53], v[52:53], v[22:23] op_sel:[0,1] op_sel_hi:[1,1]
    v_pk_mul_f32 v[54:55], v[54:55], v[22:23] op_sel:[0,1] op_sel_hi:[1,1]
    v_pk_mul_f32 v[56:57], v[56:57], v[22:23] op_sel:[0,1] op_sel_hi:[1,1]
    v_pk_mul_f32 v[58:59], v[58:59], v[22:23] op_sel:[0,1] op_sel_hi:[1,1]
    v_cvt_pk_bf16_f32 v48, v52, v53
    v_cvt_pk_bf16_f32 v49, v54, v55
    v_cvt_pk_bf16_f32 v50, v56, v57
    v_cvt_pk_bf16_f32 v51, v58, v59
    s_mov_b32 exec_hi, 0x00ffffff
    ds_write_b128 v4, v[48:51]
    s_mov_b32 exec_hi, -1
    ds_read_b128 v[72:75], v3 offset:0
    ds_read_b128 v[76:79], v3 offset:64
    ds_read_b128 v[80:83], v3 offset:128
    ds_read_b128 v[84:87], v3 offset:192
    ds_read_b128 v[88:91], v3 offset:256
    ds_read_b128 v[92:95], v3 offset:320
    ds_read_b128 v[96:99], v3 offset:384
    ds_read_b128 v[100:103], v3 offset:448
    ds_read_b128 v[104:107], v3 offset:512
    ds_read_b128 v[108:111], v3 offset:576
    ds_read_b128 v[112:115], v3 offset:640
    ds_read_b128 v[116:119], v3 offset:704
    ds_read_b128 v[120:123], v3 offset:768
    ds_read_b128 v[124:127], v3 offset:832
    s_waitcnt lgkmcnt(13)
    v_mfma_f32_16x16x32_bf16 v[32:35], v[192:195], v[72:75], 0
    s_waitcnt lgkmcnt(11)
    v_mfma_f32_16x16x32_bf16 v[32:35], v[196:199], v[76:79], v[32:35]
    v_mfma_f32_16x16x32_bf16 v[32:35], v[200:203], v[80:83], v[32:35]
    s_waitcnt lgkmcnt(8)
    v_mfma_f32_16x16x32_bf16 v[32:35], v[204:207], v[84:87], v[32:35]
    v_mfma_f32_16x16x32_bf16 v[32:35], v[208:211], v[88:91], v[32:35]
    v_mfma_f32_16x16x32_bf16 v[32:35], v[212:215], v[92:95], v[32:35]
    s_waitcnt lgkmcnt(4)
    v_mfma_f32_16x16x32_bf16 v[32:35], v[216:219], v[96:99], v[32:35]
    v_mfma_f32_16x16x32_bf16 v[32:35], v[220:223], v[100:103], v[32:35]
    v_mfma_f32_16x16x32_bf16 v[32:35], v[224:227], v[104:107], v[32:35]
    v_mfma_f32_16x16x32_bf16 v[32:35], v[228:231], v[108:111], v[32:35]
    s_waitcnt lgkmcnt(0)
    v_mfma_f32_16x16x32_bf16 v[32:35], v[232:235], v[112:115], v[32:35]
    v_mfma_f32_16x16x32_bf16 v[32:35], v[236:239], v[116:119], v[32:35]
    v_mfma_f32_16x16x32_bf16 v[32:35], v[240:243], v[120:123], v[32:35]
    v_mfma_f32_16x16x32_bf16 v[32:35], v[244:247], v[124:127], v[32:35]
    v_mov_b32 v50, s74
    v_mov_b32 v51, s76
    s_mov_b64 exec, s[4:5]
    s_nop 4
    v_cvt_pk_bf16_f32 v48, v32, v33
    v_cvt_pk_bf16_f32 v49, v34, v35
    s_cmp_lg_u32 s72, 0
    s_cbranch_scc1 L_stq_far
    buffer_store_dwordx4 v[48:51], v15, s[64:67], s84 offen
L_stq_back:
    s_mov_b64 exec, -1
    s_cmp_eq_u32 s73, 0
    s_cbranch_scc1 L_late
    s_waitcnt vmcnt(0)
L_b1_w3_back:
    buffer_load_dwordx4 v[48:51], v5, s[64:67], s84 offen sc1
    buffer_load_dwordx4 v[52:55], v5, s[64:67], s84 offen offset:1024 sc1
    s_cmp_eq_u32 s73, 0
    s_cbranch_scc1 L_b1b_w3
L_b1b_w3_back:
L_e1_chk:
    s_waitcnt vmcnt(0)
    v_cmp_ne_u32 vcc, s76, v51
    v_cmp_ne_u32 s[78:79], s76, v55
    s_or_b64 vcc, vcc, s[78:79]
    s_cbranch_scc1 L_e1_retry
L_e1_done:
    ds_write_b64 v6, v[48:49]
    ds_write_b64 v6, v[52:53] offset:576
    s_cmp_eq_u32 s73, 0
    s_cbranch_scc1 L_xcc
L_q_done:
    s_waitcnt lgkmcnt(0)
    s_barrier
    ds_read_b128 v[104:107], v7 offset:0
    ds_read_b128 v[108:111], v7 offset:64
    ds_read_b128 v[112:115], v7 offset:128
    ds_read_b128 v[116:119], v7 offset:192
    ds_read_b128 v[120:123], v7 offset:256
    ds_read_b128 v[124:127], v7 offset:320
    ds_read_b128 v[40:43], v7 offset:384
    ds_read_b128 v[44:47], v7 offset:448
    s_waitcnt lgkmcnt(7)
    v_mfma_f32_16x16x32_bf16 v[32:35], a[0:3], v[104:107], 0
    s_waitcnt lgkmcnt(6)
    v_mfma_f32_16x16x32_bf16 v[32:35], a[4:7], v[108:111], v[32:35]
    s_waitcnt lgkmcnt(5)
    v_mfma_f32_16x16x32_bf16 v[32:35], a[8:11], v[112:115], v[32:35]
    s_waitcnt lgkmcnt(4)
    v_mfma_f32_16x16x32_bf16 v[32:35], a[12:15], v[116:119], v[32:35]
    s_waitcnt lgkmcnt(3)
    v_mfma_f32_16x16x32_bf16 v[32:35], a[16:19], v[120:123], v[32:35]
    s_waitcnt lgkmcnt(2)
    v_mfma_f32_16x16x32_bf16 v[32:35], a[20:23], v[124:127], v[32:35]
    s_waitcnt lgkmcnt(1)
    v_mfma_f32_16x16x32_bf16 v[32:35], a[24:27], v[40:43], v[32:35]
    s_waitcnt lgkmcnt(0)
    v_mfma_f32_16x16x32_bf16 v[32:35], a[28:31], v[44:47], v[32:35]
    s_add_u32 s76, s71, 1
    s_mov_b64 exec, s[6:7]
    s_nop 5
    v_cvt_pk_bf16_f32 v40, v32, v33
    v_cvt_pk_bf16_f32 v41, v34, v35
    v_lshlrev_b32 v32, 16, v40
    v_and_b32 v33, s93, v40
    v_lshlrev_b32 v34, 16, v41
    v_and_b32 v35, s93, v41
    v_pk_mul_f32 v[32:33], v[32:33], s[94:95]
    v_pk_mul_f32 v[34:35], v[34:35], s[94:95]
    ds_write_b128 v8, v[32:35]
    s_mov_b64 exec, -1
    s_waitcnt lgkmcnt(0)
    s_barrier
    ds_read_b32 v250, v251
    ds_read_b128 v[40:43], v9 offset:0
    ds_read_b128 v[44:47], v9 offset:64
    s_waitcnt lgkmcnt(1)
    v_max3_f32 v56, v40, v41, v42
    v_readfirstlane_b32 s72, v250
    s_waitcnt lgkmcnt(0)
    v_max3_f32 v57, v43, v44, v45
    v_max3_f32 v56, v56, v46, v47
    v_max_f32 v56, v56, v57
    s_nop 1
    v_max_f32_dpp v56, v56, v56 quad_perm:[2,3,0,1] row_mask:0xf bank_mask:0xf
    v_mov_b32 v57, v56
    s_nop 1
    v_permlane16_swap_b32 v56, v57
    v_max_f32 v56, v56, v57
    v_mov_b32 v57, v56
    s_nop 1
    v_permlane32_swap_b32 v56, v57
    v_max_f32 v56, v56, v57
    v_pk_add_f32 v[40:41], v[40:41], v[56:57] op_sel_hi:[1,0] neg_lo:[0,1] neg_hi:[0,1]
    v_pk_add_f32 v[42:43], v[42:43], v[56:57] op_sel_hi:[1,0] neg_lo:[0,1] neg_hi:[0,1]
    v_pk_add_f32 v[44:45], v[44:45], v[56:57] op_sel_hi:[1,0] neg_lo:[0,1] neg_hi:[0,1]
    v_pk_add_f32 v[46:47], v[46:47], v[56:57] op_sel_hi:[1,0] neg_lo:[0,1] neg_hi:[0,1]
    v_exp_f32 v40, v40
    v_exp_f32 v41, v41
    v_exp_f32 v42, v42
    v_exp_f32 v43, v43
    v_exp_f32 v44, v44
    v_exp_f32 v45, v45
    v_exp_f32 v46, v46
    v_exp_f32 v47, v47
    v_cvt_pk_bf16_f32 v60, v40, v41
    v_cvt_pk_bf16_f32 v61, v42, v43
    v_cvt_pk_bf16_f32 v62, v44, v45
    v_cvt_pk_bf16_f32 v63, v46, v47
    v_mov_b32_dpp v64, v60 quad_perm:[2,3,2,3] row_mask:0xf bank_mask:0xf
    v_mov_b32_dpp v65, v61 quad_perm:[2,3,2,3] row_mask:0xf bank_mask:0xf
    v_mfma_f32_16x16x32_bf16 v[36:39], v[60:63], v[24:27], 0
    v_mov_b32_dpp v66, v62 quad_perm:[2,3,2,3] row_mask:0xf bank_mask:0xf
    v_mov_b32_dpp v67, v63 quad_perm:[2,3,2,3] row_mask:0xf bank_mask:0xf
    v_mfma_f32_16x16x32_bf16 v[104:107], v[60:63], a[32:35], 0
    v_mfma_f32_16x16x32_bf16 v[108:111], v[60:63], a[40:43], 0
    v_mfma_f32_16x16x32_bf16 v[36:39], v[64:67], v[24:27], v[36:39]
    v_mfma_f32_16x16x32_bf16 v[104:107], v[64:67], a[36:39], v[104:107]
    v_mfma_f32_16x16x32_bf16 v[108:111], v[64:67], a[44:47], v[108:111]
    v_mfma_f32_16x16x32_bf16 v[112:115], v[60:63], a[48:51], 0
    v_mfma_f32_16x16x32_bf16 v[112:115], v[64:67], a[52:55], v[112:115]
    v_mfma_f32_16x16x32_bf16 v[116:119], v[60:63], a[56:59], 0
    v_mfma_f32_16x16x32_bf16 v[116:119], v[64:67], a[60:63], v[116:119]
    v_mov_b32 v43, s76
    s_nop 2
    v_cndmask_b32 v42, v36, v37, s[10:11]
    v_cndmask_b32 v42, v56, v42, s[12:13]
    v_cndmask_b32 v40, v104, v108, s[14:15]
    v_cndmask_b32 v41, v105, v109, s[14:15]
    v_cndmask_b32 v40, v40, v112, s[16:17]
    v_cndmask_b32 v41, v41, v113, s[16:17]
    v_cndmask_b32 v40, v40, v116, s[18:19]
    v_cndmask_b32 v41, v41, v117, s[18:19]
    s_cmp_lg_u32 s72, 0
    s_cbranch_scc1 L_sto_far
    buffer_store_dwordx4 v[40:43], v10, s[64:67], 0 offen
L_sto_back:
    s_cmp_ge_u32 s70, 2
    s_cbranch_scc1 L_not_wo
    s_cmp_eq_u32 s73, 0
    s_cbranch_scc1 L_prep_wo
    s_waitcnt vmcnt(0)
    buffer_load_dwordx4 v[48:51], v11, s[64:67], 0 offen offset:0 sc1
    buffer_load_dwordx4 v[52:55], v11, s[64:67], 0 offen offset:1024 sc1
    buffer_load_dwordx4 v[56:59], v11, s[64:67], 0 offen offset:2048 sc1
    buffer_load_dwordx4 v[60:63], v11, s[64:67], 0 offen offset:3072 sc1
L_e2_chk:
    s_waitcnt vmcnt(0)
    v_cmp_ne_u32 vcc, s76, v51
    v_cmp_ne_u32 s[78:79], s76, v55
    v_cmp_ne_u32 s[80:81], s76, v59
    v_cmp_ne_u32 s[82:83], s76, v63
    s_or_b64 vcc, vcc, s[78:79]
    s_or_b64 vcc, vcc, s[80:81]
    s_or_b64 vcc, vcc, s[82:83]
    s_cbranch_scc1 L_e2_retry
L_e2_done:
    v_max3_f32 v40, v50, v54, v58
    v_max_f32 v40, v40, v62
    v_mov_b32 v32, 0
    v_mov_b32 v33, 0
    v_mov_b32 v34, 0
    v_mov_b32 v35, 0
    v_max_f32_dpp v40, v40, v40 row_ror:8 row_mask:0xf bank_mask:0xf
    v_mov_b32 v41, v40
    s_nop 1
    v_permlane16_swap_b32 v40, v41
    v_max_f32 v40, v40, v41
    v_mov_b32 v41, v40
    s_nop 1
    v_permlane32_swap_b32 v40, v41
    v_max_f32 v40, v40, v41
    v_sub_f32 v51, v50, v40
    v_sub_f32 v55, v54, v40
    v_sub_f32 v59, v58, v40
    v_sub_f32 v63, v62, v40
    v_exp_f32 v51, v51
    v_exp_f32 v55, v55
    v_exp_f32 v59, v59
    v_exp_f32 v63, v63
    s_nop 0
    v_mul_f32_dpp v42, v51, v48 quad_perm:[0,0,0,0] row_mask:0xf bank_mask:0xf
    v_mul_f32_dpp v43, v51, v49 quad_perm:[1,1,1,1] row_mask:0xf bank_mask:0xf
    v_mul_f32_dpp v44, v51, v50 quad_perm:[0,1,0,1] row_mask:0xf bank_mask:0xf
    v_fmac_f32_dpp v42, v55, v52 quad_perm:[0,0,0,0] row_mask:0xf bank_mask:0xf
    v_fmac_f32_dpp v43, v55, v53 quad_perm:[1,1,1,1] row_mask:0xf bank_mask:0xf
    v_fmac_f32_dpp v44, v55, v54 quad_perm:[0,1,0,1] row_mask:0xf bank_mask:0xf
    v_fmac_f32_dpp v42, v59, v56 quad_perm:[0,0,0,0] row_mask:0xf bank_mask:0xf
    v_fmac_f32_dpp v43, v59, v57 quad_perm:[1,1,1,1] row_mask:0xf bank_mask:0xf
    v_fmac_f32_dpp v44, v59, v58 quad_perm:[0,1,0,1] row_mask:0xf bank_mask:0xf
    v_fmac_f32_dpp v42, v63, v60 quad_perm:[0,0,0,0] row_mask:0xf bank_mask:0xf
    v_fmac_f32_dpp v43, v63, v61 quad_perm:[1,1,1,1] row_mask:0xf bank_mask:0xf
    v_fmac_f32_dpp v44, v63, v62 quad_perm:[0,1,0,1] row_mask:0xf bank_mask:0xf
    v_mov_b32 v45, v44
    s_nop 0
    v_permlane32_swap_b32 v42, v43
    v_permlane32_swap_b32 v44, v45
    v_add_f32 v42, v42, v43
    v_add_f32 v44, v44, v45
    v_mov_b32 v43, v42
    v_mov_b32 v45, v44
    s_nop 0
    v_permlane16_swap_b32 v42, v43
    v_permlane16_swap_b32 v44, v45
    v_add_f32 v42, v42, v43
    v_add_f32 v44, v44, v45
    s_nop 0
    v_add_f32_dpp v42, v42, v42 row_ror:8 row_mask:0xf bank_mask:0xf
    v_add_f32_dpp v44, v44, v44 row_ror:8 row_mask:0xf bank_mask:0xf
    v_rcp_f32 v44, v44
    s_nop 1
    v_mul_f32_dpp v42, v44, v42 quad_perm:[2,2,2,2] row_mask:0x3 bank_mask:0xf
    v_mul_f32_dpp v42, v44, v42 quad_perm:[3,3,3,3] row_mask:0xc bank_mask:0xf
    v_mov_b32 v43, v42
    s_nop 1
    v_permlane32_swap_b32 v42, v43
    v_cvt_pk_bf16_f32 v42, v42, v43
    s_add_u32 s76, s71, 2
    s_nop 0
    v_dot2c_f32_bf16_dpp v32, v42, v128 row_newbcast:0 row_mask:0xf bank_mask:0xf
    v_dot2c_f32_bf16_dpp v33, v42, v129 row_newbcast:0 row_mask:0xf bank_mask:0xf
    v_dot2c_f32_bf16_dpp v34, v42, v130 row_newbcast:0 row_mask:0xf bank_mask:0xf
    v_dot2c_f32_bf16_dpp v35, v42, v131 row_newbcast:0 row_mask:0xf bank_mask:0xf
    v_dot2c_f32_bf16_dpp v32, v42, v132 row_newbcast:1 row_mask:0xf bank_mask:0xf
    v_dot2c_f32_bf16_dpp v33, v42, v133 row_newbcast:1 row_mask:0xf bank_mask:0xf
    v_dot2c_f32_bf16_dpp v34, v42, v134 row_newbcast:1 row_mask:0xf bank_mask:0xf
    v_dot2c_f32_bf16_dpp v35, v42, v135 row_newbcast:1 row_mask:0xf bank_mask:0xf
    v_dot2c_f32_bf16_dpp v32, v42, v136 row_newbcast:2 row_mask:0xf bank_mask:0xf
    v_dot2c_f32_bf16_dpp v33, v42, v137 row_newbcast:2 row_mask:0xf bank_mask:0xf
    v_dot2c_f32_bf16_dpp v34, v42, v138 row_newbcast:2 row_mask:0xf bank_mask:0xf
    v_dot2c_f32_bf16_dpp v35, v42, v139 row_newbcast:2 row_mask:0xf bank_mask:0xf
    v_dot2c_f32_bf16_dpp v32, v42, v140 row_newbcast:3 row_mask:0xf bank_mask:0xf
    v_dot2c_f32_bf16_dpp v33, v42, v141 row_newbcast:3 row_mask:0xf bank_mask:0xf
    v_dot2c_f32_bf16_dpp v34, v42, v142 row_newbcast:3 row_mask:0xf bank_mask:0xf
    v_dot2c_f32_bf16_dpp v35, v42, v143 row_newbcast:3 row_mask:0xf bank_mask:0xf
    v_dot2c_f32_bf16_dpp v32, v42, v144 row_newbcast:4 row_mask:0xf bank_mask:0xf
    v_dot2c_f32_bf16_dpp v33, v42, v145 row_newbcast:4 row_mask:0xf bank_mask:0xf
    v_dot2c_f32_bf16_dpp v34, v42, v146 row_newbcast:4 row_mask:0xf bank_mask:0xf
    v_dot2c_f32_bf16_dpp v35, v42, v147 row_newbcast:4 row_mask:0xf bank_mask:0xf
    v_dot2c_f32_bf16_dpp v32, v42, v148 row_newbcast:5 row_mask:0xf bank_mask:0xf
    v_dot2c_f32_bf16_dpp v33, v42, v149 row_newbcast:5 row_mask:0xf bank_mask:0xf
    v_dot2c_f32_bf16_dpp v34, v42, v150 row_newbcast:5 row_mask:0xf bank_mask:0xf
    v_dot2c_f32_bf16_dpp v35, v42, v151 row_newbcast:5 row_mask:0xf bank_mask:0xf
    v_dot2c_f32_bf16_dpp v32, v42, v152 row_newbcast:6 row_mask:0xf bank_mask:0xf
    v_dot2c_f32_bf16_dpp v33, v42, v153 row_newbcast:6 row_mask:0xf bank_mask:0xf
    v_dot2c_f32_bf16_dpp v34, v42, v154 row_newbcast:6 row_mask:0xf bank_mask:0xf
    v_dot2c_f32_bf16_dpp v35, v42, v155 row_newbcast:6 row_mask:0xf bank_mask:0xf
    v_dot2c_f32_bf16_dpp v32, v42, v156 row_newbcast:7 row_mask:0xf bank_mask:0xf
    v_dot2c_f32_bf16_dpp v33, v42, v157 row_newbcast:7 row_mask:0xf bank_mask:0xf
    v_dot2c_f32_bf16_dpp v34, v42, v158 row_newbcast:7 row_mask:0xf bank_mask:0xf
    v_dot2c_f32_bf16_dpp v35, v42, v159 row_newbcast:7 row_mask:0xf bank_mask:0xf
    s_mov_b64 exec, s[8:9]
    s_nop 1
    v_perm_b32 v48, v35, v32, s90
    v_perm_b32 v49, v35, v33, s91
    v_perm_b32 v50, v35, v34, s92
    v_mov_b32 v51, s76
    s_cmp_lg_u32 s72, 0
    s_cbranch_scc1 L_str1_far
    buffer_store_dwordx4 v[48:51], v12, s[64:67], 0 offen
L_str1_back:
    s_mov_b64 exec, -1
    s_branch L_b4
L_not_wo:
    s_cmp_eq_u32 s70, 3
    s_cbranch_scc1 L_b4
    s_add_u32 s76, s71, 2
    buffer_load_dwordx4 v[48:51], v13, s[64:67], 0 offen sc1
    buffer_load_dwordx4 v[52:55], v13, s[64:67], 0 offen offset:1024 sc1
L_e3a_chk:
    s_waitcnt vmcnt(0)
    v_cmp_ne_u32 vcc, s76, v51
    v_cmp_ne_u32 s[78:79], s76, v55
    s_or_b64 vcc, vcc, s[78:79]
    s_cbranch_scc1 L_e3a_retry
L_e3a_done:
    v_perm_b32 v51, v49, v48, s88
    v_perm_b32 v51, v50, v51, s89
    v_perm_b32 v55, v53, v52, s88
    v_perm_b32 v55, v54, v55, s89
    v_pk_add_f32 v[48:49], v[48:49], v[52:53]
    v_pk_add_f32 v[50:51], v[50:51], v[54:55]
    s_nop 1
    v_permlane32_swap_b32 v48, v49
    v_permlane32_swap_b32 v50, v51
    v_add_f32 v48, v48, v49
    v_add_f32 v50, v50, v51
    s_nop 1
    v_permlane16_swap_b32 v48, v50
    v_add_f32 v48, v48, v50
    s_nop 1
    v_add_f32_dpp v48, v48, v48 row_ror:4 row_mask:0xf bank_mask:0xf
    s_nop 1
    v_add_f32_dpp v48, v48, v48 row_ror:8 row_mask:0xf bank_mask:0xf
    v_mov_b32 v50, v48
    s_nop 1
    v_permlane16_swap_b32 v48, v50
    v_mov_b32 v49, v48
    v_mov_b32 v51, v50
    s_nop 1
    v_permlane32_swap_b32 v48, v49
    v_permlane32_swap_b32 v50, v51
    s_add_u32 s76, s76, 1
    v_perm_b32 v52, v51, v48, s90
    v_perm_b32 v53, v51, v49, s91
    v_perm_b32 v54, v51, v50, s92
    v_mov_b32 v55, s76
    s_mov_b32 exec_hi, 0
    buffer_store_dwordx4 v[52:55], v14, s[64:67], s87 offen sc1
    s_mov_b64 exec, -1
    s_waitcnt vmcnt(0)
L_b4:
    s_waitcnt vmcnt(0)
L_b4n:
    s_barrier
    s_add_u32 s76, s71, 3
    s_mov_b32 s85, s87
    s_add_u32 s86, s87, 3584
    buffer_load_dwordx4 v[48:51], v1, s[64:67], s85 offen sc1
    buffer_load_dwordx4 v[52:55], v1, s[64:67], s85 offen offset:1792 sc1
    buffer_load_dwordx4 v[56:59], v1, s[64:67], s86 offen sc1
    buffer_load_dwordx4 v[60:63], v1, s[64:67], s86 offen offset:1792 sc1
    s_add_u32 s87, s87, 0x4000
    s_cmp_eq_u32 s73, 0
    s_cbranch_scc1 L_prep_mlp
L_prep_mlp_back:
L_e3b_chk:
    s_waitcnt vmcnt(0)
    v_cmp_ne_u32 vcc, s76, v51
    v_cmp_ne_u32 s[78:79], s76, v55
    v_cmp_ne_u32 s[80:81], s76, v59
    v_cmp_ne_u32 s[82:83], s76, v63
    s_or_b64 vcc, vcc, s[78:79]
    s_or_b64 vcc, vcc, s[80:81]
    s_or_b64 vcc, vcc, s[82:83]
    s_cbranch_scc1 L_e3b_retry
L_e3b_done:
    v_perm_b32 v51, v49, v48, s88
    v_perm_b32 v51, v50, v51, s89
    v_perm_b32 v55, v53, v52, s88
    v_perm_b32 v55, v54, v55, s89
    v_perm_b32 v59, v57, v56, s88
    v_perm_b32 v59, v58, v59, s89
    v_perm_b32 v63, v61, v60, s88
    v_perm_b32 v63, v62, v63, s89
    v_pk_add_f32 v[48:49], v[48:49], v[52:53]
    v_pk_add_f32 v[56:57], v[56:57], v[60:61]
    v_pk_add_f32 v[50:51], v[50:51], v[54:55]
    v_pk_add_f32 v[58:59], v[58:59], v[62:63]
    v_pk_add_f32 v[48:49], v[48:49], v[56:57]
    v_pk_add_f32 v[50:51], v[50:51], v[58:59]
    s_nop 1
    v_permlane32_swap_b32 v48, v50
    v_permlane32_swap_b32 v49, v51
    v_pk_add_f32 v[48:49], v[48:49], v[50:51]
    v_cvt_pk_bf16_f32 v50, v48, v49
    v_lshlrev_b32 v48, 16, v50
    v_and_b32 v49, s93, v50
    v_add_f32 v48, v48, v19
    v_add_f32 v49, v49, v20
    v_cvt_pk_bf16_f32 v50, v48, v49
    ds_write_b32 v2, v50
    v_lshlrev_b32 v19, 16, v50
    v_and_b32 v20, s93, v50
    s_waitcnt lgkmcnt(0)
    s_barrier
    s_add_u32 s76, s71, 4
    s_cmp_ge_u32 s70, 2
    s_cbranch_scc1 L_not_mlp
    ds_read_b128 v[48:51], v4
    ds_read_b128 v[72:75], v3 offset:0
    ds_read_b128 v[76:79], v3 offset:64
    ds_read_b128 v[80:83], v3 offset:128
    ds_read_b128 v[84:87], v3 offset:192
    ds_read_b128 v[88:91], v3 offset:256
    ds_read_b128 v[92:95], v3 offset:320
    ds_read_b128 v[96:99], v3 offset:384
    ds_read_b128 v[100:103], v3 offset:448
    ds_read_b128 v[104:107], v3 offset:512
    ds_read_b128 v[108:111], v3 offset:576
    ds_read_b128 v[112:115], v3 offset:640
    ds_read_b128 v[116:119], v3 offset:704
    ds_read_b128 v[120:123], v3 offset:768
    ds_read_b128 v[124:127], v3 offset:832
    v_mov_b32 v36, 0
    v_mov_b32 v37, 0
    s_waitcnt lgkmcnt(14)
    v_dot2c_f32_bf16 v36, v48, v24
    v_dot2c_f32_bf16 v37, v48, v48
    v_dot2c_f32_bf16 v36, v49, v24
    v_dot2c_f32_bf16 v37, v49, v49
    s_waitcnt lgkmcnt(11)
    v_mfma_f32_16x16x32_bf16 v[32:35], v[192:195], v[72:75], 0
    v_dot2c_f32_bf16 v36, v50, v24
    v_dot2c_f32_bf16 v37, v50, v50
    v_dot2c_f32_bf16 v36, v51, v24
    v_mfma_f32_16x16x32_bf16 v[56:59], v[196:199], v[76:79], 0
    v_dot2c_f32_bf16 v37, v51, v51
    v_mfma_f32_16x16x32_bf16 v[32:35], v[200:203], v[80:83], v[32:35]
    s_nop 0
    s_waitcnt lgkmcnt(7)
    v_mfma_f32_16x16x32_bf16 v[56:59], v[204:207], v[84:87], v[56:59]
    s_nop 0
    v_permlane32_swap_b32 v36, v37
    v_add_f32 v36, v36, v37
    v_mov_b32 v37, v36
    v_mfma_f32_16x16x32_bf16 v[32:35], v[208:211], v[88:91], v[32:35]
    s_nop 0
    v_permlane16_swap_b32 v36, v37
    v_add_f32 v36, v36, v37
    v_mfma_f32_16x16x32_bf16 v[56:59], v[212:215], v[92:95], v[56:59]
    s_nop 0
    v_add_f32_dpp v36, v36, v36 row_ror:8 row_mask:0xf bank_mask:0xf
    v_mfma_f32_16x16x32_bf16 v[32:35], v[216:219], v[96:99], v[32:35]
    s_nop 0
    v_add_f32_dpp v36, v36, v36 row_ror:4 row_mask:0xf bank_mask:0xf
    s_waitcnt lgkmcnt(3)
    v_mfma_f32_16x16x32_bf16 v[56:59], v[220:223], v[100:103], v[56:59]
    s_nop 0
    v_add_f32_dpp v36, v36, v36 row_ror:2 row_mask:0xf bank_mask:0xf
    v_mfma_f32_16x16x32_bf16 v[32:35], v[224:227], v[104:107], v[32:35]
    s_nop 0
    v_add_f32_dpp v36, v36, v36 row_ror:1 row_mask:0xf bank_mask:0xf
    v_mul_f32 v36, 0x3b124925, v36
    v_mov_b32 v37, v36
    v_mfma_f32_16x16x32_bf16 v[56:59], v[228:231], v[108:111], v[56:59]
    s_nop 0
    v_permlane32_swap_b32 v36, v37
    v_fma_f32 v37, -v36, v36, v37
    v_max_f32 v37, 0, v37
    v_mfma_f32_16x16x32_bf16 v[32:35], v[232:235], v[112:115], v[32:35]
    v_cvt_pk_bf16_f32 v44, v36, v37
    v_lshlrev_b32 v22, 16, v44
    v_and_b32 v44, s93, v44
    s_waitcnt lgkmcnt(0)
    v_mfma_f32_16x16x32_bf16 v[56:59], v[236:239], v[116:119], v[56:59]
    v_add_f32 v44, 0x3727c5ac, v44
    v_cvt_pk_bf16_f32 v44, v44, v44
    v_and_b32 v44, s93, v44
    v_mfma_f32_16x16x32_bf16 v[32:35], v[240:243], v[120:123], v[32:35]
    v_sqrt_f32 v44, v44
    v_pk_mul_f32 v[52:53], v[28:29], v[22:23] op_sel_hi:[1,0]
    v_cvt_pk_bf16_f32 v44, v44, v44
    v_mfma_f32_16x16x32_bf16 v[56:59], v[244:247], v[124:127], v[56:59]
    v_and_b32 v44, s93, v44
    v_pk_mul_f32 v[54:55], v[30:31], v[22:23] op_sel_hi:[1,0]
    v_rcp_f32 v23, v44
    s_nop 3
    v_pk_add_f32 v[32:33], v[32:33], v[52:53] neg_lo:[0,1] neg_hi:[0,1]
    v_pk_add_f32 v[34:35], v[34:35], v[54:55] neg_lo:[0,1] neg_hi:[0,1]
    v_pk_add_f32 v[32:33], v[32:33], v[56:57]
    v_pk_add_f32 v[34:35], v[34:35], v[58:59]
    v_pk_mul_f32 v[32:33], v[32:33], v[22:23] op_sel:[0,1] op_sel_hi:[1,1]
    v_pk_mul_f32 v[34:35], v[34:35], v[22:23] op_sel:[0,1] op_sel_hi:[1,1]
    s_nop 0
    v_permlane16_swap_b32 v32, v33
    v_permlane16_swap_b32 v34, v35
    v_cvt_pk_bf16_f32 v40, v32, v34
    v_cvt_pk_bf16_f32 v41, v33, v35
    v_lshlrev_b32 v42, 16, v40
    v_and_b32 v43, s93, v40
    v_mul_f32 v44, 0xbfb8aa3b, v42
    v_mul_f32 v45, 0xbfb8aa3b, v43
    v_exp_f32 v44, v44
    v_exp_f32 v45, v45
    v_lshlrev_b32 v46, 16, v41
    v_and_b32 v47, s93, v41
    v_add_f32 v44, 1.0, v44
    v_add_f32 v45, 1.0, v45
    v_rcp_f32 v44, v44
    v_rcp_f32 v45, v45
    v_mov_b32 v32, 0
    v_mov_b32 v33, 0
    v_mov_b32 v34, 0
    v_mov_b32 v35, 0
    v_mul_f32 v42, v42, v44
    v_mul_f32 v43, v43, v45
    v_cvt_pk_bf16_f32 v40, v42, v43
    v_lshlrev_b32 v42, 16, v40
    v_and_b32 v43, s93, v40
    v_mul_f32 v42, v42, v46
    v_mul_f32 v43, v43, v47
    v_cvt_pk_bf16_f32 v40, v42, v43
    s_nop 0
    v_readlane_b32 s22, v40, 0
    v_readlane_b32 s23, v40, 16
    v_readlane_b32 s24, v40, 32
    v_readlane_b32 s25, v40, 48
    s_mov_b64 exec, s[8:9]
    v_dot2c_f32_bf16 v32, s22, v160
    v_dot2c_f32_bf16 v33, s22, v161
    v_dot2c_f32_bf16 v34, s22, v162
    v_dot2c_f32_bf16 v35, s22, v163
    v_dot2c_f32_bf16 v32, s23, v164
    v_dot2c_f32_bf16 v33, s23, v165
    v_dot2c_f32_bf16 v34, s23, v166
    v_dot2c_f32_bf16 v35, s23, v167
    v_dot2c_f32_bf16 v32, s24, v168
    v_dot2c_f32_bf16 v33, s24, v169
    v_dot2c_f32_bf16 v34, s24, v170
    v_dot2c_f32_bf16 v35, s24, v171
    v_dot2c_f32_bf16 v32, s25, v172
    v_dot2c_f32_bf16 v33, s25, v173
    v_dot2c_f32_bf16 v34, s25, v174
    v_dot2c_f32_bf16 v35, s25, v175
    s_nop 2
    v_perm_b32 v48, v35, v32, s90
    v_perm_b32 v49, v35, v33, s91
    v_perm_b32 v50, v35, v34, s92
    v_mov_b32 v51, s76
    s_cmp_lg_u32 s72, 0
    s_cbranch_scc1 L_str2_far
    buffer_store_dwordx4 v[48:51], v12, s[64:67], 0 offen
L_str2_back:
    s_mov_b64 exec, -1
    s_branch L_b6
L_not_mlp:
    s_cmp_eq_u32 s70, 3
    s_cbranch_scc1 L_b6
    buffer_load_dwordx4 v[48:51], v13, s[64:67], 0 offen sc1
    buffer_load_dwordx4 v[52:55], v13, s[64:67], 0 offen offset:1024 sc1
L_e4a_chk:
    s_waitcnt vmcnt(0)
    v_cmp_ne_u32 vcc, s76, v51
    v_cmp_ne_u32 s[78:79], s76, v55
    s_or_b64 vcc, vcc, s[78:79]
    s_cbranch_scc1 L_e4a_retry
L_e4a_done:
    v_perm_b32 v51, v49, v48, s88
    v_perm_b32 v51, v50, v51, s89
    v_perm_b32 v55, v53, v52, s88
    v_perm_b32 v55, v54, v55, s89
    v_pk_add_f32 v[48:49], v[48:49], v[52:53]
    v_pk_add_f32 v[50:51], v[50:51], v[54:55]
    s_nop 1
    v_permlane32_swap_b32 v48, v49
    v_permlane32_swap_b32 v50, v51
    v_add_f32 v48, v48, v49
    v_add_f32 v50, v50, v51
    s_nop 1
    v_permlane16_swap_b32 v48, v50
    v_add_f32 v48, v48, v50
    s_nop 1
    v_add_f32_dpp v48, v48, v48 row_ror:4 row_mask:0xf bank_mask:0xf
    s_nop 1
    v_add_f32_dpp v48, v48, v48 row_ror:8 row_mask:0xf bank_mask:0xf
    v_mov_b32 v50, v48
    s_nop 1
    v_permlane16_swap_b32 v48, v50
    v_mov_b32 v49, v48
    v_mov_b32 v51, v50
    s_nop 1
    v_permlane32_swap_b32 v48, v49
    v_permlane32_swap_b32 v50, v51
    s_add_u32 s76, s76, 1
    v_perm_b32 v52, v51, v48, s90
    v_perm_b32 v53, v51, v49, s91
    v_perm_b32 v54, v51, v50, s92
    v_mov_b32 v55, s76
    s_mov_b32 exec_hi, 0
    buffer_store_dwordx4 v[52:55], v14, s[64:67], s87 offen sc1
    s_mov_b64 exec, -1
    s_waitcnt vmcnt(0)
L_b6:
    s_barrier
    s_add_u32 s76, s71, 5
    s_mov_b32 s85, s87
    s_add_u32 s86, s87, 3584
    s_add_u32 s87, s87, 0x4000
    s_mul_i32 s75, s73, s2
    s_cmp_lg_u32 s75, 0
    s_cbranch_scc1 L_fin
    buffer_load_dwordx4 v[48:51], v1, s[64:67], s85 offen sc1
    buffer_load_dwordx4 v[52:55], v1, s[64:67], s85 offen offset:1792 sc1
    buffer_load_dwordx4 v[56:59], v1, s[64:67], s86 offen sc1
    buffer_load_dwordx4 v[60:63], v1, s[64:67], s86 offen offset:1792 sc1
L_e4b_chk:
    s_waitcnt vmcnt(0)
    v_cmp_ne_u32 vcc, s76, v51
    v_cmp_ne_u32 s[78:79], s76, v55
    v_cmp_ne_u32 s[80:81], s76, v59
    v_cmp_ne_u32 s[82:83], s76, v63
    s_or_b64 vcc, vcc, s[78:79]
    s_or_b64 vcc, vcc, s[80:81]
    s_or_b64 vcc, vcc, s[82:83]
    s_cbranch_scc1 L_e4b_retry
L_e4b_done:
    v_perm_b32 v51, v49, v48, s88
    v_perm_b32 v51, v50, v51, s89
    v_perm_b32 v55, v53, v52, s88
    v_perm_b32 v55, v54, v55, s89
    v_perm_b32 v59, v57, v56, s88
    v_perm_b32 v59, v58, v59, s89
    v_perm_b32 v63, v61, v60, s88
    v_perm_b32 v63, v62, v63, s89
    v_pk_add_f32 v[48:49], v[48:49], v[52:53]
    v_pk_add_f32 v[56:57], v[56:57], v[60:61]
    v_pk_add_f32 v[50:51], v[50:51], v[54:55]
    v_pk_add_f32 v[58:59], v[58:59], v[62:63]
    v_pk_add_f32 v[48:49], v[48:49], v[56:57]
    v_pk_add_f32 v[50:51], v[50:51], v[58:59]
    s_nop 1
    v_permlane32_swap_b32 v48, v50
    v_permlane32_swap_b32 v49, v51
    v_pk_add_f32 v[48:49], v[48:49], v[50:51]
    v_cvt_pk_bf16_f32 v50, v48, v49
    v_lshlrev_b32 v48, 16, v50
    v_and_b32 v49, s93, v50
    v_add_f32 v48, v48, v19
    v_add_f32 v49, v49, v20
    v_cvt_pk_bf16_f32 v50, v48, v49
    ds_write_b32 v2, v50
    v_lshlrev_b32 v19, 16, v50
    v_and_b32 v20, s93, v50
    s_cmp_lg_u32 s73, 0
    s_cbranch_scc1 L_out
    s_mov_b32 s73, 1
    s_add_u32 s71, s71, 6
    s_mov_b32 s84, 20480
    s_branch L_layer
L_out:
    v_cvt_pk_bf16_f32 v40, v19, v20
    v_and_b32 v41, 31, v0
    v_lshlrev_b32 v41, 3, v41
    v_lshrrev_b32 v42, 5, v0
    v_lshl_add_u32 v41, v42, 2, v41
    s_mul_i32 s75, s70, 224
    s_mov_b64 exec, s[20:21]
    buffer_store_dword v40, v41, s[60:63], s75 offen
    s_mov_b64 exec, 1
    s_sub_u32 s75, s71, 6
    v_mov_b32 v42, s75
    v_mov_b32 v43, 0
    buffer_store_dword v42, v43, s[64:67], 0 offen sc1
    s_mov_b64 exec, -1
L_fin:
L_end:
    s_endpgm
L_kiss:
    s_waitcnt vmcnt(11)
    ds_write_b32 v2, v19
    v_and_b32 v20, s93, v19
    v_lshlrev_b32 v19, 16, v19
    buffer_load_dwordx4 a[0:3], v18, s[32:35], s98 offen offset:0 nt
    buffer_load_dwordx4 a[4:7], v18, s[32:35], s98 offen offset:64 nt
    buffer_load_dwordx4 a[8:11], v18, s[32:35], s98 offen offset:128 nt
    buffer_load_dwordx4 a[12:15], v18, s[32:35], s98 offen offset:192 nt
    buffer_load_dwordx4 a[16:19], v18, s[32:35], s98 offen offset:256 nt
    buffer_load_dwordx4 a[20:23], v18, s[32:35], s98 offen offset:320 nt
    buffer_load_dwordx4 a[24:27], v18, s[32:35], s98 offen offset:384 nt
    buffer_load_dwordx4 a[28:31], v18, s[32:35], s98 offen offset:448 nt
    s_waitcnt lgkmcnt(0)
    s_mul_i32 s71, s71, 0x9E3779B1
    s_add_u32 s71, s71, 0x7F4A7C15
    s_waitcnt vmcnt(15)
    s_branch L_kiss_back
L_prep_wq:
    v_lshrrev_b32 v40, 2, v0
    v_lshlrev_b32 v40, 5, v40
    v_and_b32 v41, 3, v0
    v_lshl_add_u32 v40, v41, 3, v40
    v_add_u32 v46, 32768, v40
    ds_read_b64_tr_b16 v[192:193], v46 offset:0
    ds_read_b64_tr_b16 v[194:195], v46 offset:512
    ds_read_b64_tr_b16 v[196:197], v46 offset:1024
    ds_read_b64_tr_b16 v[198:199], v46 offset:1536
    ds_read_b64_tr_b16 v[200:201], v46 offset:2048
    ds_read_b64_tr_b16 v[202:203], v46 offset:2560
    ds_read_b64_tr_b16 v[204:205], v46 offset:3072
    ds_read_b64_tr_b16 v[206:207], v46 offset:3584
    ds_read_b64_tr_b16 v[208:209], v46 offset:4096
    ds_read_b64_tr_b16 v[210:211], v46 offset:4608
    ds_read_b64_tr_b16 v[212:213], v46 offset:5120
    ds_read_b64_tr_b16 v[214:215], v46 offset:5632
    ds_read_b64_tr_b16 v[216:217], v46 offset:6144
    ds_read_b64_tr_b16 v[218:219], v46 offset:6656
    s_waitcnt lgkmcnt(6)
    ds_read_b64_tr_b16 v[220:221], v46 offset:7168
    ds_read_b64_tr_b16 v[222:223], v46 offset:7680
    ds_read_b64_tr_b16 v[224:225], v46 offset:8192
    ds_read_b64_tr_b16 v[226:227], v46 offset:8704
    ds_read_b64_tr_b16 v[228:229], v46 offset:9216
    ds_read_b64_tr_b16 v[230:231], v46 offset:9728
    ds_read_b64_tr_b16 v[232:233], v46 offset:10240
    ds_read_b64_tr_b16 v[234:235], v46 offset:10752
    s_waitcnt lgkmcnt(8)
    ds_read_b64_tr_b16 v[236:237], v46 offset:11264
    ds_read_b64_tr_b16 v[238:239], v46 offset:11776
    ds_read_b64_tr_b16 v[240:241], v46 offset:12288
    ds_read_b64_tr_b16 v[242:243], v46 offset:12800
    ds_read_b64_tr_b16 v[244:245], v46 offset:13312
    ds_read_b64_tr_b16 v[246:247], v46 offset:13824
    s_branch L_prep_wq_back
L_xcc:
    v_cmp_ne_u32 vcc, s74, v50
    v_cmp_ne_u32 s[78:79], s74, v54
    s_or_b64 vcc, vcc, s[78:79]
    s_cselect_b32 s75, 1, 0
    v_mov_b32 v40, s75
    v_mov_b32 v41, 66624
    ds_write_b32 v41, v40
    s_branch L_q_done
L_b1_w3:
    s_waitcnt vmcnt(0)
    s_branch L_b1_w3_back
L_not_q:
    s_cmp_lg_u32 s73, 0
    s_cbranch_scc1 L_q_done
    s_add_u32 s79, s70, 0
    s_and_b32 s75, s79, 3
    s_lshl_b32 s75, s75, 6
    s_lshl_b32 s79, s79, 10
    v_xor_b32 v49, s75, v23
    s_mov_b32 m0, s79
    s_add_u32 s78, s98, s79
    buffer_load_dwordx4 v49, s[36:39], s78 offen nt lds
    s_add_u32 s79, s70, 3
    s_and_b32 s75, s79, 3
    s_lshl_b32 s75, s75, 6
    s_lshl_b32 s79, s79, 10
    v_xor_b32 v49, s75, v23
    s_mov_b32 m0, s79
    s_add_u32 s78, s98, s79
    buffer_load_dwordx4 v49, s[36:39], s78 offen nt lds
    s_add_u32 s79, s70, 6
    s_and_b32 s75, s79, 3
    s_lshl_b32 s75, s75, 6
    s_lshl_b32 s79, s79, 10
    v_xor_b32 v49, s75, v23
    s_mov_b32 m0, s79
    s_add_u32 s78, s98, s79
    buffer_load_dwordx4 v49, s[36:39], s78 offen nt lds
    s_add_u32 s79, s70, 9
    s_and_b32 s75, s79, 3
    s_lshl_b32 s75, s75, 6
    s_lshl_b32 s79, s79, 10
    v_xor_b32 v49, s75, v23
    s_mov_b32 m0, s79
    s_add_u32 s78, s98, s79
    buffer_load_dwordx4 v49, s[36:39], s78 offen nt lds
    s_add_u32 s79, s70, 12
    s_and_b32 s75, s79, 3
    s_lshl_b32 s75, s75, 6
    s_lshl_b32 s79, s79, 10
    v_xor_b32 v49, s75, v23
    s_mov_b32 m0, s79
    s_add_u32 s78, s98, s79
    buffer_load_dwordx4 v49, s[36:39], s78 offen nt lds
    s_add_u32 s79, s70, 15
    s_and_b32 s75, s79, 3
    s_lshl_b32 s75, s75, 6
    s_lshl_b32 s79, s79, 10
    v_xor_b32 v49, s75, v23
    s_mov_b32 m0, s79
    s_add_u32 s78, s98, s79
    buffer_load_dwordx4 v49, s[36:39], s78 offen nt lds
    s_add_u32 s79, s70, 18
    s_and_b32 s75, s79, 3
    s_lshl_b32 s75, s75, 6
    s_lshl_b32 s79, s79, 10
    v_xor_b32 v49, s75, v23
    s_mov_b32 m0, s79
    s_add_u32 s78, s98, s79
    buffer_load_dwordx4 v49, s[36:39], s78 offen nt lds
    s_add_u32 s79, s70, 21
    s_and_b32 s75, s79, 3
    s_lshl_b32 s75, s75, 6
    s_lshl_b32 s79, s79, 10
    v_xor_b32 v49, s75, v23
    s_mov_b32 m0, s79
    s_add_u32 s78, s98, s79
    buffer_load_dwordx4 v49, s[36:39], s78 offen nt lds
    s_add_u32 s79, s70, 24
    s_and_b32 s75, s79, 3
    s_lshl_b32 s75, s75, 6
    s_lshl_b32 s79, s79, 10
    v_xor_b32 v49, s75, v23
    s_mov_b32 m0, s79
    s_add_u32 s78, s98, s79
    buffer_load_dwordx4 v49, s[36:39], s78 offen nt lds
    s_add_u32 s79, s70, 27
    s_and_b32 s75, s79, 3
    s_lshl_b32 s75, s75, 6
    s_lshl_b32 s79, s79, 10
    v_xor_b32 v49, s75, v23
    s_mov_b32 m0, s79
    s_add_u32 s78, s98, s79
    buffer_load_dwordx4 v49, s[36:39], s78 offen nt lds
    s_cmp_eq_u32 s70, 2
    s_cbranch_scc1 L_skip_v
    s_add_u32 s79, s70, 30
    s_and_b32 s75, s79, 3
    s_lshl_b32 s75, s75, 6
    s_lshl_b32 s79, s79, 10
    v_xor_b32 v49, s75, v23
    s_mov_b32 m0, s79
    s_add_u32 s78, s98, s79
    buffer_load_dwordx4 v49, s[36:39], s78 offen nt lds
L_skip_v:
    s_cmp_eq_u32 s70, 2
    s_cbranch_scc1 L_late
    s_min_u32 s75, s69, 27
    s_mul_i32 s78, s68, 448
    s_lshl_b32 s75, s75, 4
    s_add_u32 s78, s78, s75
    v_mul_u32_u24 v49, 3584, v0
    s_and_b32 s80, s69, 7
    s_min_u32 s80, s80, 6
    s_cmp_eq_u32 s70, 0
    s_cselect_b32 s48, s48, s52
    s_cselect_b32 s49, s49, s53
    s_cselect_b32 s81, 49152, s99
    s_lshl_b32 s75, s80, 10
    s_add_u32 m0, s75, s81
    s_mul_i32 s75, s80, 229376
    s_add_u32 s75, s75, s78
    buffer_load_dwordx4 v49, s[48:51], s75 offen lds
    s_add_u32 s80, s80, 1
    s_cmp_eq_u32 s80, 7
    s_cselect_b32 s80, 0, s80
    s_lshl_b32 s75, s80, 10
    s_add_u32 m0, s75, s81
    s_mul_i32 s75, s80, 229376
    s_add_u32 s75, s75, s78
    buffer_load_dwordx4 v49, s[48:51], s75 offen lds
    s_add_u32 s80, s80, 1
    s_cmp_eq_u32 s80, 7
    s_cselect_b32 s80, 0, s80
    s_lshl_b32 s75, s80, 10
    s_add_u32 m0, s75, s81
    s_mul_i32 s75, s80, 229376
    s_add_u32 s75, s75, s78
    buffer_load_dwordx4 v49, s[48:51], s75 offen lds
    s_add_u32 s80, s80, 1
    s_cmp_eq_u32 s80, 7
    s_cselect_b32 s80, 0, s80
    s_lshl_b32 s75, s80, 10
    s_add_u32 m0, s75, s81
    s_mul_i32 s75, s80, 229376
    s_add_u32 s75, s75, s78
    buffer_load_dwordx4 v49, s[48:51], s75 offen lds
    s_add_u32 s80, s80, 1
    s_cmp_eq_u32 s80, 7
    s_cselect_b32 s80, 0, s80
    s_lshl_b32 s75, s80, 10
    s_add_u32 m0, s75, s81
    s_mul_i32 s75, s80, 229376
    s_add_u32 s75, s75, s78
    buffer_load_dwordx4 v49, s[48:51], s75 offen lds
    s_add_u32 s80, s80, 1
    s_cmp_eq_u32 s80, 7
    s_cselect_b32 s80, 0, s80
    s_lshl_b32 s75, s80, 10
    s_add_u32 m0, s75, s81
    s_mul_i32 s75, s80, 229376
    s_add_u32 s75, s75, s78
    buffer_load_dwordx4 v49, s[48:51], s75 offen lds
    s_add_u32 s80, s80, 1
    s_cmp_eq_u32 s80, 7
    s_cselect_b32 s80, 0, s80
    s_lshl_b32 s75, s80, 10
    s_add_u32 m0, s75, s81
    s_mul_i32 s75, s80, 229376
    s_add_u32 s75, s75, s78
    buffer_load_dwordx4 v49, s[48:51], s75 offen lds
L_late:
    v_and_b32 v60, 1, v0
    v_and_b32 v61, 48, v0
    v_mul_u32_u24 v7, 576, v60
    v_add_u32 v7, v7, v61
    v_add_u32 v7, 66688, v7
    v_mul_u32_u24 v9, 320, v60
    v_add_u32 v9, v9, v61
    v_add_u32 v9, 67840, v9
    s_lshl_b32 s75, s70, 6
    v_add_u32 v8, s75, v9
    v_bfe_u32 v60, v0, 1, 1
    v_lshl_add_u32 v9, v60, 7, v9
    s_lshl_b32 s75, s68, 11
    v_lshlrev_b32 v62, 4, v0
    v_add_u32 v5, s75, v62
    v_lshlrev_b32 v6, 3, v0
    v_add_u32 v6, 66688, v6
    s_and_b32 s75, s70, 1
    s_mul_i32 s75, s75, 56
    v_min_u32 v63, 55, v0
    v_add_u32 v63, s75, v63
    v_lshlrev_b32 v17, 3, v63
    s_lshl_b32 s75, s68, 17
    s_add_u32 s75, s75, 1048576
    s_lshl_b32 s78, s69, 12
    s_add_u32 s78, s78, s75
    v_add_u32 v11, s78, v62
    s_lshl_b32 s78, s69, 7
    s_add_u32 s78, s78, s75
    s_lshl_b32 s79, s70, 15
    s_add_u32 s78, s78, s79
    v_lshrrev_b32 v10, 3, v0
    v_lshlrev_b32 v10, 12, v10
    v_and_b32 v60, 7, v0
    v_lshl_add_u32 v10, v60, 4, v10
    v_add_u32 v10, s78, v10
    s_lshl_b32 s75, s68, 16
    s_add_u32 s75, s75, 524288
    s_lshl_b32 s78, s69, 6
    s_add_u32 s78, s78, s75
    v_lshrrev_b32 v12, 2, v63
    v_lshlrev_b32 v12, 11, v12
    v_and_b32 v60, 3, v63
    v_lshl_add_u32 v12, v60, 4, v12
    v_add_u32 v12, s78, v12
    s_sub_u32 s78, s69, 4
    s_cmp_ge_u32 s69, 28
    s_cselect_b32 s78, s78, s69
    s_lshl_b32 s78, s78, 11
    s_add_u32 s78, s78, s75
    v_add_u32 v13, s78, v62
    s_mul_i32 s78, s68, 1792
    s_lshl_b32 s75, s69, 6
    s_add_u32 s78, s78, s75
    s_lshl_b32 s79, s2, 6
    s_add_u32 s79, s79, 51200
    s_cmp_ge_u32 s69, 28
    s_cselect_b32 s78, s79, s78
    v_and_b32 v60, 3, v0
    v_lshlrev_b32 v14, 4, v60
    v_add_u32 v14, s78, v14
    v_lshrrev_b32 v60, 2, v0
    v_lshl_add_u32 v14, v60, 18, v14
    s_lshl_b32 s78, s68, 18
    v_add_u32 v1, s78, v1
    s_mov_b32 s6, 0x30003
    s_mov_b32 s7, 0x30003
    s_mov_b32 s8, 0xffffffff
    s_mov_b32 s9, 0xffffff
    s_mov_b32 s10, 0xaaaaaaaa
    s_mov_b32 s11, 0xaaaaaaaa
    s_mov_b32 s12, 0xcccccccc
    s_mov_b32 s13, 0xcccccccc
    s_mov_b32 s14, 0xffff0000
    s_mov_b32 s15, 0x0
    s_mov_b32 s16, 0x0
    s_mov_b32 s17, 0xffff
    s_mov_b32 s18, 0x0
    s_mov_b32 s19, 0xffff0000
    s_mov_b32 s88, 0x0c04000c
    s_mov_b32 s89, 0x0402010c
    s_mov_b32 s90, 0x03020105
    s_mov_b32 s91, 0x03020106
    s_mov_b32 s92, 0x03020107
    s_mov_b32 s94, 0x3db8aa3b
    s_mov_b32 s95, 0x3db8aa3b
    s_mov_b32 s87, 4194304
    v_mov_b32 v251, 66624
    s_cmp_eq_u32 s70, 3
    s_cbranch_scc1 L_b1_w3
    s_cmp_eq_u32 s70, 2
    s_cbranch_scc0 L_vw01
    s_waitcnt vmcnt(0)
L_vw01:
    s_waitcnt vmcnt(7)
    s_barrier
    s_cmp_eq_u32 s70, 2
    s_cbranch_scc1 L_wide
    s_lshl_b32 s75, s68, 9
    s_lshl_b32 s78, s69, 3
    s_add_u32 s75, s75, s78
    s_mul_i32 s78, s75, 896
    buffer_load_dwordx2 v[72:73], v17, s[44:47], s78 offen offset:0 nt
    buffer_load_dwordx2 v[74:75], v17, s[44:47], s78 offen offset:896 nt
    buffer_load_dwordx2 v[76:77], v17, s[44:47], s78 offen offset:1792 nt
    buffer_load_dwordx2 v[78:79], v17, s[44:47], s78 offen offset:2688 nt
    s_add_u32 s78, s78, 3584
    buffer_load_dwordx2 v[80:81], v17, s[44:47], s78 offen offset:0 nt
    buffer_load_dwordx2 v[82:83], v17, s[44:47], s78 offen offset:896 nt
    buffer_load_dwordx2 v[84:85], v17, s[44:47], s78 offen offset:1792 nt
    buffer_load_dwordx2 v[86:87], v17, s[44:47], s78 offen offset:2688 nt
    s_add_u32 s78, s78, 225792
    buffer_load_dwordx2 v[88:89], v17, s[44:47], s78 offen offset:0 nt
    buffer_load_dwordx2 v[90:91], v17, s[44:47], s78 offen offset:896 nt
    buffer_load_dwordx2 v[92:93], v17, s[44:47], s78 offen offset:1792 nt
    buffer_load_dwordx2 v[94:95], v17, s[44:47], s78 offen offset:2688 nt
    s_add_u32 s78, s78, 3584
    buffer_load_dwordx2 v[96:97], v17, s[44:47], s78 offen offset:0 nt
    buffer_load_dwordx2 v[98:99], v17, s[44:47], s78 offen offset:896 nt
    buffer_load_dwordx2 v[100:101], v17, s[44:47], s78 offen offset:1792 nt
    buffer_load_dwordx2 v[102:103], v17, s[44:47], s78 offen offset:2688 nt
    s_add_u32 s78, s78, 225792
    s_mul_i32 s75, s68, 224
    s_lshl_b32 s78, s69, 3
    s_add_u32 s75, s75, s78
    s_mul_i32 s78, s75, 896
    s_cmp_ge_u32 s69, 28
    s_cselect_b32 s78, 0x40000000, s78
    buffer_load_dwordx2 v[176:177], v17, s[56:59], s78 offen offset:0 nt
    buffer_load_dwordx2 v[178:179], v17, s[56:59], s78 offen offset:896 nt
    buffer_load_dwordx2 v[180:181], v17, s[56:59], s78 offen offset:1792 nt
    buffer_load_dwordx2 v[182:183], v17, s[56:59], s78 offen offset:2688 nt
    s_add_u32 s78, s78, 3584
    buffer_load_dwordx2 v[184:185], v17, s[56:59], s78 offen offset:0 nt
    buffer_load_dwordx2 v[186:187], v17, s[56:59], s78 offen offset:896 nt
    buffer_load_dwordx2 v[188:189], v17, s[56:59], s78 offen offset:1792 nt
    buffer_load_dwordx2 v[190:191], v17, s[56:59], s78 offen offset:2688 nt
L_pv:
    v_lshrrev_b32 v64, 2, v0
    v_and_b32 v65, 7, v64
    s_lshl_b32 s75, s70, 2
    v_xor_b32 v65, s75, v65
    v_lshlrev_b32 v65, 5, v65
    v_lshl_add_u32 v64, v64, 9, v65
    v_and_b32 v65, 3, v0
    v_lshl_add_u32 v64, v65, 3, v64
    v_xor_b32 v65, 32, v64
    v_xor_b32 v66, 64, v64
    v_xor_b32 v67, 96, v64
    ds_read_b64_tr_b16 a[32:33], v64 offset:0
    ds_read_b64_tr_b16 a[34:35], v64 offset:8192
    ds_read_b64_tr_b16 a[36:37], v64 offset:16384
    ds_read_b64_tr_b16 a[38:39], v64 offset:24576
    ds_read_b64_tr_b16 a[40:41], v65 offset:0
    ds_read_b64_tr_b16 a[42:43], v65 offset:8192
    ds_read_b64_tr_b16 a[44:45], v65 offset:16384
    ds_read_b64_tr_b16 a[46:47], v65 offset:24576
    s_waitcnt lgkmcnt(4)
    ds_read_b64_tr_b16 a[48:49], v66 offset:0
    ds_read_b64_tr_b16 a[50:51], v66 offset:8192
    ds_read_b64_tr_b16 a[52:53], v66 offset:16384
    ds_read_b64_tr_b16 a[54:55], v66 offset:24576
    ds_read_b64_tr_b16 a[56:57], v67 offset:0
    ds_read_b64_tr_b16 a[58:59], v67 offset:8192
    ds_read_b64_tr_b16 a[60:61], v67 offset:16384
    ds_read_b64_tr_b16 a[62:63], v67 offset:24576
    s_waitcnt lgkmcnt(0)
    s_branch L_q_done
L_wide:
    buffer_load_dword v248, v13, s[64:67], 0 offen offset:0 sc1
    buffer_load_dword v248, v13, s[64:67], 0 offen offset:1024 sc1
    s_mov_b32 s75, 20480
    buffer_load_dword v248, v5, s[64:67], s75 offen sc1
    buffer_load_dword v248, v5, s[64:67], s75 offen offset:1024 sc1
    buffer_load_dword v248, v11, s[64:67], 0 offen offset:0 sc1
    buffer_load_dword v248, v11, s[64:67], 0 offen offset:1024 sc1
    buffer_load_dword v248, v11, s[64:67], 0 offen offset:2048 sc1
    buffer_load_dword v248, v11, s[64:67], 0 offen offset:3072 sc1
    s_branch L_pv
L_b1b_w3:
    s_barrier
    v_lshrrev_b32 v64, 2, v0
    v_and_b32 v65, 7, v64
    s_lshl_b32 s75, s70, 2
    v_xor_b32 v65, s75, v65
    v_lshlrev_b32 v65, 5, v65
    v_lshl_add_u32 v64, v64, 9, v65
    v_and_b32 v65, 3, v0
    v_lshl_add_u32 v64, v65, 3, v64
    v_xor_b32 v65, 32, v64
    v_xor_b32 v66, 64, v64
    v_xor_b32 v67, 96, v64
    ds_read_b64_tr_b16 a[32:33], v64 offset:0
    ds_read_b64_tr_b16 a[34:35], v64 offset:8192
    ds_read_b64_tr_b16 a[36:37], v64 offset:16384
    ds_read_b64_tr_b16 a[38:39], v64 offset:24576
    ds_read_b64_tr_b16 a[40:41], v65 offset:0
    ds_read_b64_tr_b16 a[42:43], v65 offset:8192
    ds_read_b64_tr_b16 a[44:45], v65 offset:16384
    ds_read_b64_tr_b16 a[46:47], v65 offset:24576
    s_waitcnt lgkmcnt(4)
    ds_read_b64_tr_b16 a[48:49], v66 offset:0
    ds_read_b64_tr_b16 a[50:51], v66 offset:8192
    ds_read_b64_tr_b16 a[52:53], v66 offset:16384
    ds_read_b64_tr_b16 a[54:55], v66 offset:24576
    ds_read_b64_tr_b16 a[56:57], v67 offset:0
    ds_read_b64_tr_b16 a[58:59], v67 offset:8192
    ds_read_b64_tr_b16 a[60:61], v67 offset:16384
    ds_read_b64_tr_b16 a[62:63], v67 offset:24576
    s_waitcnt lgkmcnt(0)
    s_branch L_b1b_w3_back
L_prep_wo:
    buffer_load_dwordx4 v[48:51], v11, s[64:67], 0 offen offset:0 sc1
    buffer_load_dwordx4 v[52:55], v11, s[64:67], 0 offen offset:1024 sc1
    buffer_load_dwordx4 v[56:59], v11, s[64:67], 0 offen offset:2048 sc1
    buffer_load_dwordx4 v[60:63], v11, s[64:67], 0 offen offset:3072 sc1
    s_waitcnt vmcnt(12)
    s_mov_b32 s26, 0x05040100
    s_mov_b32 s27, 0x07060302
    v_perm_b32 v128, v88, v72, s26
    v_perm_b32 v129, v88, v72, s27
    v_perm_b32 v130, v89, v73, s26
    v_perm_b32 v131, v89, v73, s27
    v_perm_b32 v132, v90, v74, s26
    v_perm_b32 v133, v90, v74, s27
    v_perm_b32 v134, v91, v75, s26
    v_perm_b32 v135, v91, v75, s27
    v_perm_b32 v136, v92, v76, s26
    v_perm_b32 v137, v92, v76, s27
    v_perm_b32 v138, v93, v77, s26
    v_perm_b32 v139, v93, v77, s27
    v_perm_b32 v140, v94, v78, s26
    v_perm_b32 v141, v94, v78, s27
    v_perm_b32 v142, v95, v79, s26
    v_perm_b32 v143, v95, v79, s27
    v_perm_b32 v144, v96, v80, s26
    v_perm_b32 v145, v96, v80, s27
    v_perm_b32 v146, v97, v81, s26
    v_perm_b32 v147, v97, v81, s27
    v_perm_b32 v148, v98, v82, s26
    v_perm_b32 v149, v98, v82, s27
    v_perm_b32 v150, v99, v83, s26
    v_perm_b32 v151, v99, v83, s27
    v_perm_b32 v152, v100, v84, s26
    v_perm_b32 v153, v100, v84, s27
    v_perm_b32 v154, v101, v85, s26
    v_perm_b32 v155, v101, v85, s27
    v_perm_b32 v156, v102, v86, s26
    v_perm_b32 v157, v102, v86, s27
    v_perm_b32 v158, v103, v87, s26
    v_perm_b32 v159, v103, v87, s27
    s_branch L_e2_chk
L_prep_mlp:
    s_cmp_ge_u32 s70, 2
    s_cbranch_scc1 L_prep_mlp_back
    v_lshrrev_b32 v40, 2, v0
    v_lshlrev_b32 v40, 4, v40
    v_bfe_u32 v41, v0, 1, 1
    v_lshl_add_u32 v40, v41, 3, v40
    v_and_b32 v41, 1, v0
    v_mul_u32_u24 v41, 8320, v41
    v_add_u32 v40, v40, v41
    v_add_u32 v18, 49152, v40
    ds_read_b64_tr_b16 v[192:193], v18 offset:0
    ds_read_b64_tr_b16 v[194:195], v18 offset:256
    ds_read_b64_tr_b16 v[196:197], v18 offset:512
    ds_read_b64_tr_b16 v[198:199], v18 offset:768
    ds_read_b64_tr_b16 v[200:201], v18 offset:1024
    ds_read_b64_tr_b16 v[202:203], v18 offset:1280
    ds_read_b64_tr_b16 v[204:205], v18 offset:1536
    ds_read_b64_tr_b16 v[206:207], v18 offset:1792
    ds_read_b64_tr_b16 v[208:209], v18 offset:2048
    ds_read_b64_tr_b16 v[210:211], v18 offset:2304
    ds_read_b64_tr_b16 v[212:213], v18 offset:2560
    ds_read_b64_tr_b16 v[214:215], v18 offset:2816
    ds_read_b64_tr_b16 v[216:217], v18 offset:3072
    ds_read_b64_tr_b16 v[218:219], v18 offset:3328
    s_waitcnt lgkmcnt(12)
    v_mfma_f32_16x16x32_bf16 v[28:31], v[192:195], v[24:27], 0
    ds_read_b64_tr_b16 v[220:221], v18 offset:3584
    ds_read_b64_tr_b16 v[222:223], v18 offset:3840
    s_waitcnt lgkmcnt(12)
    v_mfma_f32_16x16x32_bf16 v[28:31], v[196:199], v[24:27], v[28:31]
    ds_read_b64_tr_b16 v[224:225], v18 offset:4096
    ds_read_b64_tr_b16 v[226:227], v18 offset:4352
    s_waitcnt lgkmcnt(12)
    v_mfma_f32_16x16x32_bf16 v[28:31], v[200:203], v[24:27], v[28:31]
    ds_read_b64_tr_b16 v[228:229], v18 offset:4608
    ds_read_b64_tr_b16 v[230:231], v18 offset:4864
    s_waitcnt lgkmcnt(12)
    v_mfma_f32_16x16x32_bf16 v[28:31], v[204:207], v[24:27], v[28:31]
    ds_read_b64_tr_b16 v[232:233], v18 offset:5120
    ds_read_b64_tr_b16 v[234:235], v18 offset:5376
    s_waitcnt lgkmcnt(12)
    v_mfma_f32_16x16x32_bf16 v[28:31], v[208:211], v[24:27], v[28:31]
    ds_read_b64_tr_b16 v[236:237], v18 offset:5632
    ds_read_b64_tr_b16 v[238:239], v18 offset:5888
    s_waitcnt lgkmcnt(12)
    v_mfma_f32_16x16x32_bf16 v[28:31], v[212:215], v[24:27], v[28:31]
    ds_read_b64_tr_b16 v[240:241], v18 offset:6144
    ds_read_b64_tr_b16 v[242:243], v18 offset:6400
    s_waitcnt lgkmcnt(12)
    v_mfma_f32_16x16x32_bf16 v[28:31], v[216:219], v[24:27], v[28:31]
    ds_read_b64_tr_b16 v[244:245], v18 offset:6656
    ds_read_b64_tr_b16 v[246:247], v18 offset:6912
    s_waitcnt lgkmcnt(12)
    v_mfma_f32_16x16x32_bf16 v[28:31], v[220:223], v[24:27], v[28:31]
    s_waitcnt lgkmcnt(10)
    v_mfma_f32_16x16x32_bf16 v[28:31], v[224:227], v[24:27], v[28:31]
    s_waitcnt lgkmcnt(8)
    v_mfma_f32_16x16x32_bf16 v[28:31], v[228:231], v[24:27], v[28:31]
    s_waitcnt lgkmcnt(6)
    v_mfma_f32_16x16x32_bf16 v[28:31], v[232:235], v[24:27], v[28:31]
    s_waitcnt lgkmcnt(4)
    v_mfma_f32_16x16x32_bf16 v[28:31], v[236:239], v[24:27], v[28:31]
    s_waitcnt lgkmcnt(2)
    v_mfma_f32_16x16x32_bf16 v[28:31], v[240:243], v[24:27], v[28:31]
    s_waitcnt lgkmcnt(0)
    v_mfma_f32_16x16x32_bf16 v[28:31], v[244:247], v[24:27], v[28:31]
    v_perm_b32 v160, v180, v176, s26
    v_perm_b32 v161, v180, v176, s27
    v_perm_b32 v162, v181, v177, s26
    v_perm_b32 v163, v181, v177, s27
    v_perm_b32 v164, v182, v178, s26
    v_perm_b32 v165, v182, v178, s27
    v_perm_b32 v166, v183, v179, s26
    v_perm_b32 v167, v183, v179, s27
    v_perm_b32 v168, v188, v184, s26
    v_perm_b32 v169, v188, v184, s27
    v_perm_b32 v170, v189, v185, s26
    v_perm_b32 v171, v189, v185, s27
    v_perm_b32 v172, v190, v186, s26
    v_perm_b32 v173, v190, v186, s27
    v_perm_b32 v174, v191, v187, s26
    v_perm_b32 v175, v191, v187, s27
    s_branch L_prep_mlp_back
L_e1_retry:
    s_add_u32 s77, s77, 1
    s_cmp_ge_u32 s77, 400000
    s_cbranch_scc1 L_e1_done
    buffer_load_dwordx4 v[48:51], v5, s[64:67], s84 offen sc1
    buffer_load_dwordx4 v[52:55], v5, s[64:67], s84 offen offset:1024 sc1
    s_branch L_e1_chk
L_e2_retry:
    s_add_u32 s77, s77, 1
    s_cmp_ge_u32 s77, 400000
    s_cbranch_scc1 L_e2_done
    buffer_load_dwordx4 v[48:51], v11, s[64:67], 0 offen offset:0 sc1
    buffer_load_dwordx4 v[52:55], v11, s[64:67], 0 offen offset:1024 sc1
    buffer_load_dwordx4 v[56:59], v11, s[64:67], 0 offen offset:2048 sc1
    buffer_load_dwordx4 v[60:63], v11, s[64:67], 0 offen offset:3072 sc1
    s_branch L_e2_chk
L_e3a_retry:
    s_add_u32 s77, s77, 1
    s_cmp_ge_u32 s77, 400000
    s_cbranch_scc1 L_e3a_done
    buffer_load_dwordx4 v[48:51], v13, s[64:67], 0 offen sc1
    buffer_load_dwordx4 v[52:55], v13, s[64:67], 0 offen offset:1024 sc1
    s_branch L_e3a_chk
L_e3b_retry:
    s_add_u32 s77, s77, 1
    s_cmp_ge_u32 s77, 400000
    s_cbranch_scc1 L_e3b_done
    buffer_load_dwordx4 v[48:51], v1, s[64:67], s85 offen sc1
    buffer_load_dwordx4 v[52:55], v1, s[64:67], s85 offen offset:1792 sc1
    buffer_load_dwordx4 v[56:59], v1, s[64:67], s86 offen sc1
    buffer_load_dwordx4 v[60:63], v1, s[64:67], s86 offen offset:1792 sc1
    s_branch L_e3b_chk
L_e4a_retry:
    s_add_u32 s77, s77, 1
    s_cmp_ge_u32 s77, 400000
    s_cbranch_scc1 L_e4a_done
    buffer_load_dwordx4 v[48:51], v13, s[64:67], 0 offen sc1
    buffer_load_dwordx4 v[52:55], v13, s[64:67], 0 offen offset:1024 sc1
    s_branch L_e4a_chk
L_e4b_retry:
    s_add_u32 s77, s77, 1
    s_cmp_ge_u32 s77, 400000
    s_cbranch_scc1 L_e4b_done
    buffer_load_dwordx4 v[48:51], v1, s[64:67], s85 offen sc1
    buffer_load_dwordx4 v[52:55], v1, s[64:67], s85 offen offset:1792 sc1
    buffer_load_dwordx4 v[56:59], v1, s[64:67], s86 offen sc1
    buffer_load_dwordx4 v[60:63], v1, s[64:67], s86 offen offset:1792 sc1
    s_branch L_e4b_chk
L_stq_far:
    buffer_store_dwordx4 v[48:51], v15, s[64:67], s84 offen sc1
    s_branch L_stq_back
L_sto_far:
    buffer_store_dwordx4 v[40:43], v10, s[64:67], 0 offen sc1
    s_branch L_sto_back
L_str1_far:
    buffer_store_dwordx4 v[48:51], v12, s[64:67], 0 offen sc1
    s_branch L_str1_back
L_str2_far:
    buffer_store_dwordx4 v[48:51], v12, s[64:67], 0 offen sc1
    s_branch L_str2_back
.section .rodata,"a"
.p2align 6
.amdhsa_kernel interleave_layers__sliding_block_cached__glu_gated_swiglu__decode_kernel
  .amdhsa_next_free_vgpr 320
  .amdhsa_next_free_sgpr 102
  .amdhsa_accum_offset 256
  .amdhsa_group_segment_fixed_size 0
  .amdhsa_kernarg_size 96
  .amdhsa_user_sgpr_count 2
  .amdhsa_user_sgpr_kernarg_segment_ptr 1
  .amdhsa_system_sgpr_workgroup_id_x 1
  .amdhsa_float_denorm_mode_32 3
.end_amdhsa_kernel
```
